```python
import torch

def _softmax(x, axis=-1):
    return torch.softmax(x, dim=axis)
def _gelu(x):
    return torch.nn.functional.gelu(x, approximate="tanh")
def _silu(x):
    return torch.nn.functional.silu(x)
def _sigmoid(x):
    return torch.sigmoid(x)
def _layernorm(x, axis=-1, eps=1e-5):
    m = x.mean(dim=axis, keepdim=True)
    v = x.var(dim=axis, keepdim=True, unbiased=False)
    return (x - m) / torch.sqrt(v + eps)
def _scatter_add(tgt, idx, src, axis=0):
    return tgt.clone().index_add_(axis, idx, src)
def _segment_sum(src, seg, n):
    out = torch.zeros((n,) + src.shape[1:], dtype=src.dtype)
    return out.index_add_(0, seg, src)
def _pad(x, pw):
    flat = tuple(v for pair in reversed(pw) for v in pair)
    return torch.nn.functional.pad(x, flat)

kernel_name = 'concat_heads__sliding_block_cached__sliding_block_cached__decode'

def setup_inputs():

    _w = (lambda a: (lambda t: t.to(torch.bfloat16) if t.is_floating_point() else t)(torch.as_tensor(a)))
    def _A_setup():
        B, Sq, D = 8, 1, 512
        Hq, Hkv, Sk, Dh = 32, 8, 8192, 128
        assert Hq % Hkv == 0, (Hq, Hkv)
        return {
            "x": _w((lambda *s: torch.randn(*s, dtype=torch.bfloat16) * 0.8)(B, Sq, D)),
            "k_cache": _w((lambda *s: torch.randn(*s, dtype=torch.bfloat16) * 0.8)(B, Hkv, Sk, Dh)),
            "v_cache": _w((lambda *s: torch.randn(*s, dtype=torch.bfloat16) * 0.05)(B, Hkv, Sk, Dh)),
            "wq": _w((lambda *s: torch.randn(*s, dtype=torch.bfloat16) * 0.8)(D, Hq * Dh) * (D ** -0.5)),
            "wo": _w((lambda *s: torch.randn(*s, dtype=torch.bfloat16) * 0.05)(Hq * Dh, D) * ((Hq * Dh) ** -0.5)),
        }
    _A_in = _A_setup()

    def _B_setup():
        B, Sq, D = 8, 1, 512
        Hq, Hkv, Sk, Dh = 32, 8, 8192, 128
        assert Hq % Hkv == 0, (Hq, Hkv)
        return {
            "x": _w((lambda *s: torch.randn(*s, dtype=torch.bfloat16) * 0.8)(B, Sq, D)),
            "k_cache": _w((lambda *s: torch.randn(*s, dtype=torch.bfloat16) * 0.8)(B, Hkv, Sk, Dh)),
            "v_cache": _w((lambda *s: torch.randn(*s, dtype=torch.bfloat16) * 0.05)(B, Hkv, Sk, Dh)),
            "wq": _w((lambda *s: torch.randn(*s, dtype=torch.bfloat16) * 0.8)(D, Hq * Dh) * (D ** -0.5)),
            "wo": _w((lambda *s: torch.randn(*s, dtype=torch.bfloat16) * 0.05)(Hq * Dh, D) * ((Hq * Dh) ** -0.5)),
        }
    _B_in = _B_setup()

    return {
        "A_x": _A_in["x"],
        "A_k_cache": _A_in["k_cache"],
        "A_v_cache": _A_in["v_cache"],
        "A_wq": _A_in["wq"],
        "A_wo": _A_in["wo"],
        "B_x": _B_in["x"],
        "B_k_cache": _B_in["k_cache"],
        "B_v_cache": _B_in["v_cache"],
        "B_wq": _B_in["wq"],
        "B_wo": _B_in["wo"],
    }

def reference(A_x, A_k_cache, A_v_cache, A_wq, A_wo, B_x, B_k_cache, B_v_cache, B_wq, B_wo):
    def _A_ref(x, k_cache, v_cache, wq, wo):
        B, Sq, D = x.shape
        Hq, Dh = 32, 128
        Hkv, Sk = k_cache.shape[1], k_cache.shape[2]
        W = min(4096, max(256, Sk // 4))
        rep = Hq // Hkv
        q = (lambda x, *d: x.permute(*d))((x @ wq).reshape(B, Sq, Hq, Dh), 0, 2, 1, 3)
        k = (lambda x, n, axis: torch.repeat_interleave(x, n, dim=axis))(k_cache[:, :, Sk - W:, :], rep, axis=1)
        v = (lambda x, n, axis: torch.repeat_interleave(x, n, dim=axis))(v_cache[:, :, Sk - W:, :], rep, axis=1)
        scores = torch.einsum("bhqd,bhkd->bhqk", q, k) * (Dh ** -0.5)
        p = _softmax(scores, axis=-1)
        o = torch.einsum("bhqk,bhkd->bhqd", p, v)
        return (lambda x, *d: x.permute(*d))(o, 0, 2, 1, 3).reshape(B, Sq, Hq * Dh) @ wo

    def _B_ref(x, k_cache, v_cache, wq, wo):
        B, Sq, D = x.shape
        Hq, Dh = 32, 128
        Hkv, Sk = k_cache.shape[1], k_cache.shape[2]
        W = min(4096, max(256, Sk // 4))
        rep = Hq // Hkv
        q = (lambda x, *d: x.permute(*d))((x @ wq).reshape(B, Sq, Hq, Dh), 0, 2, 1, 3)
        k = (lambda x, n, axis: torch.repeat_interleave(x, n, dim=axis))(k_cache[:, :, Sk - W:, :], rep, axis=1)
        v = (lambda x, n, axis: torch.repeat_interleave(x, n, dim=axis))(v_cache[:, :, Sk - W:, :], rep, axis=1)
        scores = torch.einsum("bhqd,bhkd->bhqk", q, k) * (Dh ** -0.5)
        p = _softmax(scores, axis=-1)
        o = torch.einsum("bhqk,bhkd->bhqd", p, v)
        return (lambda x, *d: x.permute(*d))(o, 0, 2, 1, 3).reshape(B, Sq, Hq * Dh) @ wo

    a = _A_ref(A_x, A_k_cache, A_v_cache, A_wq, A_wo)
    b = _B_ref(B_x, B_k_cache, B_v_cache, B_wq, B_wo)
    return torch.concatenate([a, b], axis=-1)
```

```asm
; @launch grid=(256,1,1) block=(512,1,1) lds=67584
.amdgcn_target "amdgcn-amd-amdhsa--gfx950"
.text
.globl concat_heads__sliding_block_cached__sliding_block_cached__decode_kernel
.p2align 8
.type concat_heads__sliding_block_cached__sliding_block_cached__decode_kernel,@function
concat_heads__sliding_block_cached__sliding_block_cached__decode_kernel:
    s_cmp_ge_u32 s2, 256
    s_cbranch_scc1 L_end
    s_lshr_b32 s5, s2, 7
    s_mul_i32 s7, s5, 40
    s_add_u32 s64, s0, s7
    s_addc_u32 s65, s1, 0
    s_load_dwordx8 s[8:15], s[64:65], 0
    s_load_dwordx2 s[22:23], s[0:1], 96
    s_load_dwordx2 s[16:17], s[64:65], 32
    s_load_dwordx2 s[18:19], s[0:1], 80
    s_and_b32 s4, s2, 7
    s_bfe_u32 s6, s2, 0x40003
    v_lshrrev_b32 v2, 6, v0
    v_and_b32 v1, 63, v0
    v_readfirstlane_b32 s3, v2
    v_lshrrev_b32 v2, 4, v1
    v_and_b32 v3, 15, v1
    v_lshlrev_b32 v4, 16, v2
    v_lshl_add_u32 v10, v3, 2, v4
    v_and_b32 v4, 3, v3
    v_lshlrev_b32 v13, 13, v4
    s_cmp_eq_u32 s4, 7
    s_cselect_b32 s7, 4, 0
    v_and_b32 v5, s7, v1
    v_lshl_add_u32 v12, v5, 7, v13
    v_and_b32 v5, 12, v3
    v_lshlrev_b32 v5, 6, v5
    v_lshl_add_u32 v5, v2, 6, v5
    v_lshl_add_u32 v8, v4, 4, v5
    v_lshlrev_b32 v9, 4, v1
    s_lshr_b32 s66, s6, 1
    s_and_b32 s67, s6, 1
    v_and_b32 v4, 7, v3
    v_lshlrev_b32 v4, 10, v4
    v_lshl_add_u32 v11, v2, 4, v4
    s_lshl_b32 s7, s67, 3
    v_xor_b32 v4, s7, v3
    v_and_b32 v4, 8, v4
    v_lshl_add_u32 v11, v4, 3, v11
    s_lshl_b32 s62, s4, 4
    s_add_u32 s62, s62, s6
    s_lshl_b32 s63, s3, 19
    s_lshl_b32 s69, s62, 6
    s_add_u32 s63, s63, s69
    s_lshl_b32 s60, s6, 18
    s_lshl_b32 s7, s3, 15
    s_add_u32 s60, s60, s7
    s_lshl_b32 s7, s4, 10
    s_add_u32 s60, s60, s7
    s_lshl_b32 s21, s67, 18
    s_add_u32 s63, s63, s21
    s_mov_b32 s30, 0x400000
    s_mov_b32 s31, 0x20000
    s_lshl_b32 s20, s3, 7
    s_mov_b32 s26, 8192
    s_mov_b32 s27, 0x20000
    s_lshl_b32 s68, s66, 3
    s_add_u32 s68, s68, s4
    s_lshl_b32 s68, s68, 21
    s_lshl_b32 s7, s67, 15
    s_add_u32 s68, s68, s7
    s_lshl_b32 s7, s3, 12
    s_add_u32 s68, s68, s7
    s_add_u32 s68, s68, 1572864
    s_mov_b32 s34, 462848
    s_mov_b32 s35, 0x20000
    s_lshl_b32 s61, s5, 8
    s_waitcnt lgkmcnt(0)
    s_mov_b32 s28, s14
    s_mov_b32 s29, s15
    buffer_load_dword v31, v12, s[28:31], s60 offen offset:384
    s_load_dword s52, s[22:23], s61
    s_mov_b32 s24, s8
    s_mov_b32 s25, s9
    s_mov_b32 s59, s20
    buffer_load_dword v64, v10, s[28:31], s63 offen nt
    s_xor_b32 s60, s63, 8192
    buffer_load_dword v65, v10, s[28:31], s60 offen nt
    s_xor_b32 s60, s63, 16384
    buffer_load_dword v66, v10, s[28:31], s60 offen nt
    s_xor_b32 s60, s63, 24576
    buffer_load_dword v67, v10, s[28:31], s60 offen nt
    s_xor_b32 s60, s63, 32768
    buffer_load_dword v68, v10, s[28:31], s60 offen nt
    s_xor_b32 s60, s63, 40960
    buffer_load_dword v69, v10, s[28:31], s60 offen nt
    s_xor_b32 s60, s63, 49152
    buffer_load_dword v70, v10, s[28:31], s60 offen nt
    s_xor_b32 s60, s63, 57344
    buffer_load_dword v71, v10, s[28:31], s60 offen nt
    s_xor_b32 s60, s63, 262144
    buffer_load_dword v72, v10, s[28:31], s60 offen nt
    s_xor_b32 s60, s63, 270336
    buffer_load_dword v73, v10, s[28:31], s60 offen nt
    s_xor_b32 s60, s63, 278528
    buffer_load_dword v74, v10, s[28:31], s60 offen nt
    s_xor_b32 s60, s63, 286720
    buffer_load_dword v75, v10, s[28:31], s60 offen nt
    s_xor_b32 s60, s63, 294912
    buffer_load_dword v76, v10, s[28:31], s60 offen nt
    s_xor_b32 s60, s63, 303104
    buffer_load_dword v77, v10, s[28:31], s60 offen nt
    s_xor_b32 s60, s63, 311296
    buffer_load_dword v78, v10, s[28:31], s60 offen nt
    s_xor_b32 s60, s63, 319488
    buffer_load_dword v79, v10, s[28:31], s60 offen nt
    s_add_u32 s32, s10, s68
    s_addc_u32 s33, s11, 0
    s_mov_b32 s44, s22
    s_mov_b32 s45, s23
    s_mov_b32 s46, 1310720
    s_mov_b32 s47, 0x20000
    s_lshl_b32 s7, s5, 6
    s_add_u32 s7, s7, s4
    s_mul_i32 s20, s7, 2048
    s_add_u32 s20, s20, 262144
    s_mul_i32 s7, s3, 16384
    s_add_u32 s57, s20, s7
    v_mov_b32 v28, 0
    v_mov_b32 v29, 0
    v_mov_b32 v30, 0
    ds_write_b96 v28, v[28:30] offset:1280
    ds_write_b32 v28, v28 offset:1292
L_noclear:
    s_waitcnt lgkmcnt(0)
    s_barrier
    buffer_load_dwordx4 v[128:131], v8, s[32:35], 0 offen offset:0 nt
    buffer_load_dwordx4 v[132:135], v8, s[32:35], 0 offen offset:1024 nt
    s_add_u32 s36, s12, s68
    s_addc_u32 s37, s13, 0
    s_mov_b32 s38, 462848
    s_mov_b32 s39, 0x20000
    s_mov_b32 s48, s18
    s_mov_b32 s49, s19
    s_mov_b32 s50, 16384
    s_mov_b32 s51, 0x20000
    s_mov_b32 s53, 0x05040100
    s_mov_b32 s54, 0x07060302
    s_mov_b32 s55, 0x3fb8aa3b
    s_lshl_b32 s69, s4, 19
    s_lshl_b32 s7, s67, 18
    s_add_u32 s69, s69, s7
    s_lshl_b32 s7, s3, 15
    s_add_u32 s69, s69, s7
    s_lshl_b32 s7, s66, 7
    s_add_u32 s69, s69, s7
    s_add_u32 s40, s16, s69
    s_addc_u32 s41, s17, 0
    s_mov_b32 s42, 31872
    s_mov_b32 s43, 0x20000
    s_getreg_b32 s21, hwreg(HW_REG_XCC_ID, 0, 4)
    v_bfe_u32 v4, v1, 3, 2
    v_lshlrev_b32 v12, 13, v4
    v_lshrrev_b32 v5, 5, v1
    v_lshl_add_u32 v12, v5, 10, v12
    v_and_b32 v4, 2, v4
    v_and_b32 v5, 7, v1
    v_xor_b32 v4, v4, v5
    v_lshl_add_u32 v12, v4, 4, v12
    v_xor_b32 v13, 64, v12
    s_lshl_b32 s7, s3, 12
    s_add_u32 m0, s7, 34816
    s_lshl_b32 s7, s3, 11
    s_add_u32 s7, s7, 17920
    v_mul_u32_u24 v4, 144, v3
    v_lshl_add_u32 v14, v2, 5, v4
    v_add_u32 v14, s7, v14
    v_mov_b32 v29, 1
    s_add_u32 s52, s52, 0x9E3779B9
    buffer_load_dwordx4 v[80:83], v11, s[24:27], s59 offen
    s_waitcnt vmcnt(3)
    buffer_load_dwordx4 v[136:139], v8, s[32:35], 0 offen offset:2048 nt
    s_waitcnt vmcnt(3)
    buffer_load_dwordx4 v[140:143], v8, s[32:35], 0 offen offset:3072 nt
    s_waitcnt vmcnt(2)
    s_mov_b32 s56, 65536
    buffer_load_dwordx4 v[144:147], v8, s[32:35], s56 offen offset:0 nt
    v_mov_b32_dpp v84, v80 row_ror:8 row_mask:0xf bank_mask:0xf
    v_mov_b32_dpp v85, v81 row_ror:8 row_mask:0xf bank_mask:0xf
    v_mov_b32_dpp v86, v82 row_ror:8 row_mask:0xf bank_mask:0xf
    v_mov_b32_dpp v87, v83 row_ror:8 row_mask:0xf bank_mask:0xf
    v_perm_b32 v88, v65, v64, s53
    v_perm_b32 v89, v67, v66, s53
    v_perm_b32 v90, v69, v68, s53
    v_perm_b32 v91, v71, v70, s53
    v_perm_b32 v92, v65, v64, s54
    v_perm_b32 v93, v67, v66, s54
    v_perm_b32 v94, v69, v68, s54
    v_perm_b32 v95, v71, v70, s54
    v_perm_b32 v96, v73, v72, s53
    v_perm_b32 v97, v75, v74, s53
    v_perm_b32 v98, v77, v76, s53
    v_perm_b32 v99, v79, v78, s53
    v_perm_b32 v100, v73, v72, s54
    v_perm_b32 v101, v75, v74, s54
    v_perm_b32 v102, v77, v76, s54
    v_perm_b32 v103, v79, v78, s54
    v_mfma_f32_16x16x32_bf16 v[104:107], v[88:91], v[80:83], 0
    v_mfma_f32_16x16x32_bf16 v[108:111], v[92:95], v[80:83], 0
    v_mfma_f32_16x16x32_bf16 v[104:107], v[96:99], v[84:87], v[104:107]
    v_mfma_f32_16x16x32_bf16 v[108:111], v[100:103], v[84:87], v[108:111]
    s_mov_b32 exec_lo, 0x00ff00ff
    s_mov_b32 exec_hi, 0x00ff00ff
    s_nop 5
    ds_write2_b32 v14, v104, v108 offset0:0 offset1:1
    ds_write2_b32 v14, v105, v109 offset0:2 offset1:3
    ds_write2_b32 v14, v106, v110 offset0:4 offset1:5
    ds_write2_b32 v14, v107, v111 offset0:6 offset1:7
    s_mov_b64 exec, 1
    ds_add_u32 v28, v29 offset:1280
    s_mov_b64 exec, -1
    s_waitcnt vmcnt(2)
    buffer_load_dwordx4 v[148:151], v8, s[32:35], s56 offen offset:1024 nt
    s_waitcnt vmcnt(2)
    buffer_load_dwordx4 v[152:155], v8, s[32:35], s56 offen offset:2048 nt
    s_cmp_lg_u32 s3, 2
    s_cbranch_scc1 L_q_published
    v_lshrrev_b32 v6, 3, v1
    v_and_b32 v7, 7, v1
    v_mul_u32_u24 v4, 144, v6
    v_lshl_add_u32 v4, v7, 4, v4
L_cw1:
    ds_read_b32 v30, v28 offset:1280
    s_waitcnt lgkmcnt(0)
    v_readfirstlane_b32 s7, v30
    s_cmp_lt_u32 s7, 8
    s_cbranch_scc1 L_cw1
    ds_read_b128 v[88:91], v4 offset:17920
    ds_read_b128 v[92:95], v4 offset:19968
    ds_read_b128 v[96:99], v4 offset:22016
    ds_read_b128 v[100:103], v4 offset:24064
    ds_read_b128 v[104:107], v4 offset:26112
    ds_read_b128 v[108:111], v4 offset:28160
    ds_read_b128 v[112:115], v4 offset:30208
    ds_read_b128 v[116:119], v4 offset:32256
    v_mul_u32_u24 v5, 16384, v6
    v_lshl_add_u32 v5, v7, 4, v5
    s_lshl_b32 s7, s5, 6
    s_add_u32 s7, s7, s4
    s_mul_i32 s7, s7, 2048
    v_lshl_add_u32 v6, v6, 1, s6
    v_and_b32 v6, 15, v6
    v_lshl_add_u32 v5, v6, 7, v5
    s_add_u32 s7, s7, 262144
    s_xor_b32 s69, s52, s21
    v_mov_b32 v25, s69
    v_mov_b32 v27, s69
    s_waitcnt lgkmcnt(0)
    v_pk_add_f32 v[88:89], v[88:89], v[104:105]
    v_pk_add_f32 v[90:91], v[90:91], v[106:107]
    v_pk_add_f32 v[92:93], v[92:93], v[108:109]
    v_pk_add_f32 v[94:95], v[94:95], v[110:111]
    v_pk_add_f32 v[96:97], v[96:97], v[112:113]
    v_pk_add_f32 v[98:99], v[98:99], v[114:115]
    v_pk_add_f32 v[100:101], v[100:101], v[116:117]
    v_pk_add_f32 v[102:103], v[102:103], v[118:119]
    v_pk_add_f32 v[88:89], v[88:89], v[96:97]
    v_pk_add_f32 v[90:91], v[90:91], v[98:99]
    v_pk_add_f32 v[92:93], v[92:93], v[100:101]
    v_pk_add_f32 v[94:95], v[94:95], v[102:103]
    v_pk_add_f32 v[88:89], v[88:89], v[92:93]
    v_pk_add_f32 v[90:91], v[90:91], v[94:95]
    v_cvt_pk_bf16_f32 v24, v88, v89
    v_cvt_pk_bf16_f32 v26, v90, v91
    buffer_store_dwordx4 v[24:27], v5, s[44:47], s7 offen
    ds_write_b128 v9, v[24:27] offset:1536
    s_mov_b64 exec, 1
    ds_add_u32 v28, v29 offset:1292
    s_mov_b64 exec, -1
L_q_published:
    s_cmp_eq_u32 s66, 3
    s_cselect_b32 s96, 10, 0
    s_cmp_ge_u32 s62, 126
    s_cselect_b32 s96, 10, s96
    s_lshl_b32 s59, s5, 3
    s_add_u32 s59, s59, s66
    s_lshl_b32 s59, s59, 3
    s_add_u32 s59, s59, s4
    s_mul_i32 s59, s59, 2048
    s_add_u32 s69, s3, s66
    s_and_b32 s69, s69, 7
    s_lshl_b32 s69, s69, 8
    s_add_u32 s59, s59, s69
    s_add_u32 s59, s59, 262144
    v_lshlrev_b32 v15, 4, v3
    s_lshl_b32 s7, s3, 7
    s_add_u32 s7, s7, 0
    v_lshlrev_b32 v14, 3, v3
    v_add_u32 v14, s7, v14
    s_waitcnt vmcnt(3)
    s_cmp_ge_u32 s96, 1
    s_cbranch_scc1 L_bo1
    s_waitcnt vmcnt(2)
L_bo1:
    buffer_load_dwordx4 v[156:159], v8, s[32:35], s56 offen offset:3072 nt
    s_waitcnt vmcnt(3)
    s_cmp_ge_u32 s96, 2
    s_cbranch_scc1 L_bo2
    s_waitcnt vmcnt(2)
L_bo2:
    s_mov_b32 s56, 131072
    buffer_load_dwordx4 v[160:163], v8, s[32:35], s56 offen offset:0 nt
    s_waitcnt vmcnt(3)
    s_cmp_ge_u32 s96, 3
    s_cbranch_scc1 L_bo3
    s_waitcnt vmcnt(2)
L_bo3:
    buffer_load_dwordx4 v[164:167], v8, s[32:35], s56 offen offset:1024 nt
    s_waitcnt vmcnt(3)
    s_cmp_ge_u32 s96, 4
    s_cbranch_scc1 L_bo4
    s_waitcnt vmcnt(2)
L_bo4:
    buffer_load_dwordx4 v[168:171], v8, s[32:35], s56 offen offset:2048 nt
    s_waitcnt vmcnt(3)
    s_cmp_ge_u32 s96, 5
    s_cbranch_scc1 L_bo5
    s_waitcnt vmcnt(2)
L_bo5:
    buffer_load_dwordx4 v[172:175], v8, s[32:35], s56 offen offset:3072 nt
    s_waitcnt vmcnt(3)
    s_cmp_ge_u32 s96, 6
    s_cbranch_scc1 L_bo6
    s_waitcnt vmcnt(2)
L_bo6:
    s_mov_b32 s56, 196608
    buffer_load_dwordx4 v[176:179], v8, s[32:35], s56 offen offset:0 nt
    s_waitcnt vmcnt(3)
    s_cmp_ge_u32 s96, 7
    s_cbranch_scc1 L_bo7
    s_waitcnt vmcnt(2)
L_bo7:
    buffer_load_dwordx4 v[180:183], v8, s[32:35], s56 offen offset:1024 nt
    s_waitcnt vmcnt(3)
    s_cmp_ge_u32 s96, 8
    s_cbranch_scc1 L_bo8
    s_waitcnt vmcnt(2)
L_bo8:
    buffer_load_dwordx4 v[184:187], v8, s[32:35], s56 offen offset:2048 nt
    s_waitcnt vmcnt(3)
    s_cmp_ge_u32 s96, 9
    s_cbranch_scc1 L_bo9
    s_waitcnt vmcnt(2)
L_bo9:
    buffer_load_dwordx4 v[188:191], v8, s[32:35], s56 offen offset:3072 nt
    s_waitcnt vmcnt(3)
    s_cmp_ge_u32 s96, 10
    s_cbranch_scc1 L_bo10
    s_waitcnt vmcnt(2)
L_bo10:
    s_mov_b32 s56, 262144
    buffer_load_dwordx4 v[192:195], v8, s[32:35], s56 offen offset:0 nt
    s_waitcnt vmcnt(2)
    buffer_load_dwordx4 v[196:199], v8, s[32:35], s56 offen offset:1024 nt
    s_waitcnt vmcnt(2)
    buffer_load_dwordx4 v[200:203], v8, s[32:35], s56 offen offset:2048 nt
    s_waitcnt vmcnt(2)
    buffer_load_dwordx4 v[204:207], v8, s[32:35], s56 offen offset:3072 nt
    s_waitcnt vmcnt(2)
    s_mov_b32 s56, 327680
    buffer_load_dwordx4 v[208:211], v8, s[32:35], s56 offen offset:0 nt
    buffer_load_dwordx4 v[4:7], v15, s[44:47], s59 offen sc1
    s_waitcnt vmcnt(3)
    buffer_load_dwordx4 v[212:215], v8, s[32:35], s56 offen offset:1024 nt
    s_waitcnt vmcnt(3)
    buffer_load_dwordx4 v[216:219], v8, s[32:35], s56 offen offset:2048 nt
    s_waitcnt vmcnt(2)
    buffer_load_dwordx4 v[220:223], v8, s[32:35], s56 offen offset:3072 nt
    v_xor_b32 v5, s52, v5
    v_xor_b32 v7, s52, v7
    v_cmp_ne_u32 vcc, s21, v5
    v_cmp_ne_u32 s[64:65], s21, v7
    s_or_b64 vcc, vcc, s[64:65]
    s_cbranch_scc1 L_qslow
L_qok:
    ds_write2_b32 v14, v4, v6 offset0:0 offset1:1
    v_cmp_ne_u32 vcc, s21, v5
    v_cmp_ne_u32 s[64:65], s21, v7
    s_or_b64 vcc, vcc, s[64:65]
    s_cselect_b32 s7, 0x101, 1
    v_mov_b32 v30, s7
    s_mov_b64 exec, 1
    ds_add_u32 v28, v30 offset:1284
    s_mov_b64 exec, -1
    v_and_b32 v5, 3, v3
    v_lshlrev_b32 v15, 6, v5
    s_lshl_b32 s7, s3, 3
    v_add_u32 v15, s7, v15
    v_lshlrev_b32 v20, 8, v5
    v_lshl_add_u32 v20, v2, 6, v20
    v_and_b32 v5, 12, v3
    v_lshl_add_u32 v20, v5, 2, v20
    s_waitcnt vmcnt(2)
    s_mov_b32 s56, 393216
    buffer_load_dwordx4 v[224:227], v8, s[32:35], s56 offen offset:0 nt
    s_waitcnt vmcnt(2)
    buffer_load_dwordx4 v[228:231], v8, s[32:35], s56 offen offset:1024 nt
    s_waitcnt vmcnt(2)
    buffer_load_dwordx4 v[232:235], v8, s[32:35], s56 offen offset:2048 nt
L_cwq:
    ds_read_b32 v30, v28 offset:1284
    s_waitcnt lgkmcnt(0)
    v_readfirstlane_b32 s58, v30
    s_and_b32 s7, s58, 0xff
    s_cmp_lt_u32 s7, 8
    s_cbranch_scc1 L_cwq
    ds_read_b128 v[16:19], v20 offset:0
    s_waitcnt lgkmcnt(0)
    v_mfma_f32_16x16x32_bf16 v[48:51], v[128:131], v[16:19], 0
    v_mfma_f32_16x16x32_bf16 v[52:55], v[132:135], v[16:19], 0
    v_mfma_f32_16x16x32_bf16 v[56:59], v[136:139], v[16:19], 0
    v_mfma_f32_16x16x32_bf16 v[60:63], v[140:143], v[16:19], 0
    s_waitcnt vmcnt(2)
    buffer_load_dwordx4 v[236:239], v8, s[32:35], s56 offen offset:3072 nt
    v_mfma_f32_16x16x32_bf16 v[128:131], v[144:147], v[16:19], 0
    v_mfma_f32_16x16x32_bf16 v[132:135], v[148:151], v[16:19], 0
    v_mfma_f32_16x16x32_bf16 v[136:139], v[152:155], v[16:19], 0
    v_mfma_f32_16x16x32_bf16 v[140:143], v[156:159], v[16:19], 0
    v_add_f32_dpp v48, v49, v48 row_ror:12 row_mask:0xf bank_mask:0xf
    v_add_f32_dpp v52, v53, v52 row_ror:12 row_mask:0xf bank_mask:0xf
    v_add_f32_dpp v56, v57, v56 row_ror:12 row_mask:0xf bank_mask:0xf
    v_add_f32_dpp v60, v61, v60 row_ror:12 row_mask:0xf bank_mask:0xf
    v_add_f32_dpp v48, v50, v48 row_ror:8 row_mask:0xf bank_mask:0xf
    v_add_f32_dpp v52, v54, v52 row_ror:8 row_mask:0xf bank_mask:0xf
    v_add_f32_dpp v56, v58, v56 row_ror:8 row_mask:0xf bank_mask:0xf
    v_add_f32_dpp v60, v62, v60 row_ror:8 row_mask:0xf bank_mask:0xf
    v_add_f32_dpp v32, v51, v48 row_ror:4 row_mask:0xf bank_mask:0x1
    v_add_f32_dpp v33, v55, v52 row_ror:4 row_mask:0xf bank_mask:0x1
    v_add_f32_dpp v34, v59, v56 row_ror:4 row_mask:0xf bank_mask:0x1
    v_add_f32_dpp v35, v63, v60 row_ror:4 row_mask:0xf bank_mask:0x1
    s_waitcnt vmcnt(2)
    s_mov_b32 s56, 458752
    buffer_load_dwordx4 v[240:243], v8, s[32:35], s56 offen offset:0 nt
    v_mfma_f32_16x16x32_bf16 v[144:147], v[160:163], v[16:19], 0
    v_mfma_f32_16x16x32_bf16 v[148:151], v[164:167], v[16:19], 0
    v_mfma_f32_16x16x32_bf16 v[152:155], v[168:171], v[16:19], 0
    v_mfma_f32_16x16x32_bf16 v[156:159], v[172:175], v[16:19], 0
    v_add_f32_dpp v128, v129, v128 row_ror:12 row_mask:0xf bank_mask:0xf
    v_add_f32_dpp v132, v133, v132 row_ror:12 row_mask:0xf bank_mask:0xf
    v_add_f32_dpp v136, v137, v136 row_ror:12 row_mask:0xf bank_mask:0xf
    v_add_f32_dpp v140, v141, v140 row_ror:12 row_mask:0xf bank_mask:0xf
    v_add_f32_dpp v128, v130, v128 row_ror:8 row_mask:0xf bank_mask:0xf
    v_add_f32_dpp v132, v134, v132 row_ror:8 row_mask:0xf bank_mask:0xf
    v_add_f32_dpp v136, v138, v136 row_ror:8 row_mask:0xf bank_mask:0xf
    v_add_f32_dpp v140, v142, v140 row_ror:8 row_mask:0xf bank_mask:0xf
    v_add_f32_dpp v36, v131, v128 row_ror:4 row_mask:0xf bank_mask:0x1
    v_add_f32_dpp v37, v135, v132 row_ror:4 row_mask:0xf bank_mask:0x1
    v_add_f32_dpp v38, v139, v136 row_ror:4 row_mask:0xf bank_mask:0x1
    v_add_f32_dpp v39, v143, v140 row_ror:4 row_mask:0xf bank_mask:0x1
    s_waitcnt vmcnt(2)
    buffer_load_dwordx4 v[244:247], v8, s[32:35], s56 offen offset:1024 nt
    v_mfma_f32_16x16x32_bf16 v[160:163], v[176:179], v[16:19], 0
    v_mfma_f32_16x16x32_bf16 v[164:167], v[180:183], v[16:19], 0
    v_mfma_f32_16x16x32_bf16 v[168:171], v[184:187], v[16:19], 0
    v_mfma_f32_16x16x32_bf16 v[172:175], v[188:191], v[16:19], 0
    v_add_f32_dpp v145, v146, v145 row_ror:12 row_mask:0xf bank_mask:0xf
    v_add_f32_dpp v149, v150, v149 row_ror:12 row_mask:0xf bank_mask:0xf
    v_add_f32_dpp v153, v154, v153 row_ror:12 row_mask:0xf bank_mask:0xf
    v_add_f32_dpp v157, v158, v157 row_ror:12 row_mask:0xf bank_mask:0xf
    v_add_f32_dpp v145, v147, v145 row_ror:8 row_mask:0xf bank_mask:0xf
    v_add_f32_dpp v149, v151, v149 row_ror:8 row_mask:0xf bank_mask:0xf
    v_add_f32_dpp v153, v155, v153 row_ror:8 row_mask:0xf bank_mask:0xf
    v_add_f32_dpp v157, v159, v157 row_ror:8 row_mask:0xf bank_mask:0xf
    v_add_f32_dpp v32, v144, v145 row_ror:4 row_mask:0xf bank_mask:0x2
    v_add_f32_dpp v33, v148, v149 row_ror:4 row_mask:0xf bank_mask:0x2
    v_add_f32_dpp v34, v152, v153 row_ror:4 row_mask:0xf bank_mask:0x2
    v_add_f32_dpp v35, v156, v157 row_ror:4 row_mask:0xf bank_mask:0x2
    s_waitcnt vmcnt(2)
    buffer_load_dwordx4 v[248:251], v8, s[32:35], s56 offen offset:2048 nt
    v_mfma_f32_16x16x32_bf16 v[176:179], v[192:195], v[16:19], 0
    v_mfma_f32_16x16x32_bf16 v[180:183], v[196:199], v[16:19], 0
    v_mfma_f32_16x16x32_bf16 v[184:187], v[200:203], v[16:19], 0
    v_mfma_f32_16x16x32_bf16 v[188:191], v[204:207], v[16:19], 0
    v_add_f32_dpp v161, v162, v161 row_ror:12 row_mask:0xf bank_mask:0xf
    v_add_f32_dpp v165, v166, v165 row_ror:12 row_mask:0xf bank_mask:0xf
    v_add_f32_dpp v169, v170, v169 row_ror:12 row_mask:0xf bank_mask:0xf
    v_add_f32_dpp v173, v174, v173 row_ror:12 row_mask:0xf bank_mask:0xf
    v_add_f32_dpp v161, v163, v161 row_ror:8 row_mask:0xf bank_mask:0xf
    v_add_f32_dpp v165, v167, v165 row_ror:8 row_mask:0xf bank_mask:0xf
    v_add_f32_dpp v169, v171, v169 row_ror:8 row_mask:0xf bank_mask:0xf
    v_add_f32_dpp v173, v175, v173 row_ror:8 row_mask:0xf bank_mask:0xf
    v_add_f32_dpp v36, v160, v161 row_ror:4 row_mask:0xf bank_mask:0x2
    v_add_f32_dpp v37, v164, v165 row_ror:4 row_mask:0xf bank_mask:0x2
    v_add_f32_dpp v38, v168, v169 row_ror:4 row_mask:0xf bank_mask:0x2
    v_add_f32_dpp v39, v172, v173 row_ror:4 row_mask:0xf bank_mask:0x2
    s_waitcnt vmcnt(2)
    buffer_load_dwordx4 v[252:255], v8, s[32:35], s56 offen offset:3072 nt
    v_mfma_f32_16x16x32_bf16 v[192:195], v[208:211], v[16:19], 0
    v_mfma_f32_16x16x32_bf16 v[196:199], v[212:215], v[16:19], 0
    v_mfma_f32_16x16x32_bf16 v[200:203], v[216:219], v[16:19], 0
    v_mfma_f32_16x16x32_bf16 v[204:207], v[220:223], v[16:19], 0
    v_add_f32_dpp v178, v179, v178 row_ror:12 row_mask:0xf bank_mask:0xf
    v_add_f32_dpp v182, v183, v182 row_ror:12 row_mask:0xf bank_mask:0xf
    v_add_f32_dpp v186, v187, v186 row_ror:12 row_mask:0xf bank_mask:0xf
    v_add_f32_dpp v190, v191, v190 row_ror:12 row_mask:0xf bank_mask:0xf
    v_add_f32_dpp v178, v176, v178 row_ror:8 row_mask:0xf bank_mask:0xf
    v_add_f32_dpp v182, v180, v182 row_ror:8 row_mask:0xf bank_mask:0xf
    v_add_f32_dpp v186, v184, v186 row_ror:8 row_mask:0xf bank_mask:0xf
    v_add_f32_dpp v190, v188, v190 row_ror:8 row_mask:0xf bank_mask:0xf
    v_add_f32_dpp v32, v177, v178 row_ror:4 row_mask:0xf bank_mask:0x4
    v_add_f32_dpp v33, v181, v182 row_ror:4 row_mask:0xf bank_mask:0x4
    v_add_f32_dpp v34, v185, v186 row_ror:4 row_mask:0xf bank_mask:0x4
    v_add_f32_dpp v35, v189, v190 row_ror:4 row_mask:0xf bank_mask:0x4
    s_waitcnt vmcnt(2)
    buffer_load_dwordx4 v[64:67], v9, s[36:39], 0 offen offset:0 nt
    v_mfma_f32_16x16x32_bf16 v[208:211], v[224:227], v[16:19], 0
    v_mfma_f32_16x16x32_bf16 v[212:215], v[228:231], v[16:19], 0
    v_mfma_f32_16x16x32_bf16 v[216:219], v[232:235], v[16:19], 0
    v_mfma_f32_16x16x32_bf16 v[220:223], v[236:239], v[16:19], 0
    v_add_f32_dpp v194, v195, v194 row_ror:12 row_mask:0xf bank_mask:0xf
    v_add_f32_dpp v198, v199, v198 row_ror:12 row_mask:0xf bank_mask:0xf
    v_add_f32_dpp v202, v203, v202 row_ror:12 row_mask:0xf bank_mask:0xf
    v_add_f32_dpp v206, v207, v206 row_ror:12 row_mask:0xf bank_mask:0xf
    v_add_f32_dpp v194, v192, v194 row_ror:8 row_mask:0xf bank_mask:0xf
    v_add_f32_dpp v198, v196, v198 row_ror:8 row_mask:0xf bank_mask:0xf
    v_add_f32_dpp v202, v200, v202 row_ror:8 row_mask:0xf bank_mask:0xf
    v_add_f32_dpp v206, v204, v206 row_ror:8 row_mask:0xf bank_mask:0xf
    v_add_f32_dpp v36, v193, v194 row_ror:4 row_mask:0xf bank_mask:0x4
    v_add_f32_dpp v37, v197, v198 row_ror:4 row_mask:0xf bank_mask:0x4
    v_add_f32_dpp v38, v201, v202 row_ror:4 row_mask:0xf bank_mask:0x4
    v_add_f32_dpp v39, v205, v206 row_ror:4 row_mask:0xf bank_mask:0x4
    s_waitcnt vmcnt(2)
    buffer_load_dwordx4 v[68:71], v9, s[36:39], 0 offen offset:1024 nt
    s_waitcnt vmcnt(2)
    buffer_load_dwordx4 v[72:75], v9, s[36:39], 0 offen offset:2048 nt
    v_mfma_f32_16x16x32_bf16 v[224:227], v[240:243], v[16:19], 0
    v_mfma_f32_16x16x32_bf16 v[228:231], v[244:247], v[16:19], 0
    v_mfma_f32_16x16x32_bf16 v[232:235], v[248:251], v[16:19], 0
    v_mfma_f32_16x16x32_bf16 v[236:239], v[252:255], v[16:19], 0
    v_add_f32_dpp v211, v208, v211 row_ror:12 row_mask:0xf bank_mask:0xf
    v_add_f32_dpp v215, v212, v215 row_ror:12 row_mask:0xf bank_mask:0xf
    v_add_f32_dpp v219, v216, v219 row_ror:12 row_mask:0xf bank_mask:0xf
    v_add_f32_dpp v223, v220, v223 row_ror:12 row_mask:0xf bank_mask:0xf
    v_add_f32_dpp v211, v209, v211 row_ror:8 row_mask:0xf bank_mask:0xf
    v_add_f32_dpp v215, v213, v215 row_ror:8 row_mask:0xf bank_mask:0xf
    v_add_f32_dpp v219, v217, v219 row_ror:8 row_mask:0xf bank_mask:0xf
    v_add_f32_dpp v223, v221, v223 row_ror:8 row_mask:0xf bank_mask:0xf
    v_add_f32_dpp v32, v210, v211 row_ror:4 row_mask:0xf bank_mask:0x8
    v_add_f32_dpp v33, v214, v215 row_ror:4 row_mask:0xf bank_mask:0x8
    v_add_f32_dpp v34, v218, v219 row_ror:4 row_mask:0xf bank_mask:0x8
    v_add_f32_dpp v35, v222, v223 row_ror:4 row_mask:0xf bank_mask:0x8
    v_add_f32_dpp v227, v224, v227 row_ror:12 row_mask:0xf bank_mask:0xf
    v_add_f32_dpp v231, v228, v231 row_ror:12 row_mask:0xf bank_mask:0xf
    v_add_f32_dpp v235, v232, v235 row_ror:12 row_mask:0xf bank_mask:0xf
    v_add_f32_dpp v239, v236, v239 row_ror:12 row_mask:0xf bank_mask:0xf
    v_add_f32_dpp v227, v225, v227 row_ror:8 row_mask:0xf bank_mask:0xf
    v_add_f32_dpp v231, v229, v231 row_ror:8 row_mask:0xf bank_mask:0xf
    v_add_f32_dpp v235, v233, v235 row_ror:8 row_mask:0xf bank_mask:0xf
    v_add_f32_dpp v239, v237, v239 row_ror:8 row_mask:0xf bank_mask:0xf
    v_add_f32_dpp v36, v226, v227 row_ror:4 row_mask:0xf bank_mask:0x8
    v_add_f32_dpp v37, v230, v231 row_ror:4 row_mask:0xf bank_mask:0x8
    v_add_f32_dpp v38, v234, v235 row_ror:4 row_mask:0xf bank_mask:0x8
    v_add_f32_dpp v39, v238, v239 row_ror:4 row_mask:0xf bank_mask:0x8
    v_cvt_pk_bf16_f32 v40, v32, v33
    v_cvt_pk_bf16_f32 v41, v34, v35
    v_cvt_pk_bf16_f32 v42, v36, v37
    v_cvt_pk_bf16_f32 v43, v38, v39
    v_lshlrev_b32 v32, 16, v40
    v_and_b32 v33, 0xffff0000, v40
    v_lshlrev_b32 v34, 16, v41
    v_and_b32 v35, 0xffff0000, v41
    v_lshlrev_b32 v36, 16, v42
    v_and_b32 v37, 0xffff0000, v42
    v_lshlrev_b32 v38, 16, v43
    v_and_b32 v39, 0xffff0000, v43
    v_mul_f32 v32, 0x3db504f3, v32
    v_mul_f32 v33, 0x3db504f3, v33
    v_mul_f32 v34, 0x3db504f3, v34
    v_mul_f32 v35, 0x3db504f3, v35
    v_mul_f32 v36, 0x3db504f3, v36
    v_mul_f32 v37, 0x3db504f3, v37
    v_mul_f32 v38, 0x3db504f3, v38
    v_mul_f32 v39, 0x3db504f3, v39
    v_cvt_pk_bf16_f32 v40, v32, v33
    v_cvt_pk_bf16_f32 v41, v34, v35
    v_cvt_pk_bf16_f32 v42, v36, v37
    v_cvt_pk_bf16_f32 v43, v38, v39
    v_lshlrev_b32 v32, 16, v40
    v_and_b32 v33, 0xffff0000, v40
    v_lshlrev_b32 v34, 16, v41
    v_and_b32 v35, 0xffff0000, v41
    v_lshlrev_b32 v36, 16, v42
    v_and_b32 v37, 0xffff0000, v42
    v_lshlrev_b32 v38, 16, v43
    v_and_b32 v39, 0xffff0000, v43
    v_max3_f32 v4, v32, v33, v34
    v_max3_f32 v5, v35, v36, v37
    v_max3_f32 v4, v4, v38, v39
    v_max_f32 v4, v4, v5
    s_nop 1
    v_max_f32_dpp v4, v4, v4 row_ror:4 row_mask:0xf bank_mask:0xf
    s_nop 1
    v_max_f32_dpp v4, v4, v4 row_ror:8 row_mask:0xf bank_mask:0xf
    v_mov_b32 v5, v4
    s_nop 1
    v_permlane32_swap_b32 v4, v5
    v_max_f32 v4, v4, v5
    v_mov_b32 v5, v4
    s_nop 1
    v_permlane16_swap_b32 v4, v5
    v_max_f32 v4, v4, v5
    v_mul_f32 v6, s55, v4
    v_fma_f32 v32, v32, s55, -v6
    v_fma_f32 v33, v33, s55, -v6
    v_fma_f32 v34, v34, s55, -v6
    v_fma_f32 v35, v35, s55, -v6
    v_fma_f32 v36, v36, s55, -v6
    v_fma_f32 v37, v37, s55, -v6
    v_fma_f32 v38, v38, s55, -v6
    v_fma_f32 v39, v39, s55, -v6
    v_exp_f32 v32, v32
    v_exp_f32 v33, v33
    v_exp_f32 v34, v34
    v_exp_f32 v35, v35
    v_exp_f32 v36, v36
    v_exp_f32 v37, v37
    v_exp_f32 v38, v38
    v_exp_f32 v39, v39
    s_waitcnt vmcnt(2)
    buffer_load_dwordx4 v[76:79], v9, s[36:39], 0 offen offset:3072 nt
    v_add_f32 v5, v32, v33
    v_add_f32 v7, v34, v35
    v_add_f32 v5, v5, v36
    v_add_f32 v7, v7, v37
    v_add_f32 v5, v5, v38
    v_add_f32 v7, v7, v39
    v_add_f32 v5, v5, v7
    v_cvt_pk_bf16_f32 v224, v32, v33
    v_cvt_pk_bf16_f32 v225, v34, v35
    v_cvt_pk_bf16_f32 v226, v36, v37
    v_cvt_pk_bf16_f32 v227, v38, v39
    v_add_f32_dpp v5, v5, v5 row_ror:4 row_mask:0xf bank_mask:0xf
    s_nop 1
    v_add_f32_dpp v5, v5, v5 row_ror:8 row_mask:0xf bank_mask:0xf
    v_mov_b32 v7, v5
    s_nop 1
    v_permlane32_swap_b32 v5, v7
    v_add_f32 v5, v5, v7
    v_mov_b32 v7, v5
    s_nop 1
    v_permlane16_swap_b32 v5, v7
    v_add_f32 v7, v5, v7
    s_mov_b64 exec, 15
    ds_write_b64 v15, v[6:7] offset:1024
    s_mov_b64 exec, 1
    ds_add_u32 v28, v29 offset:1288
    s_mov_b64 exec, -1
    v_mov_b32_dpp v228, v224 row_ror:12 row_mask:0xf bank_mask:0xf
    v_mov_b32_dpp v229, v225 row_ror:12 row_mask:0xf bank_mask:0xf
    v_mov_b32_dpp v230, v226 row_ror:12 row_mask:0xf bank_mask:0xf
    v_mov_b32_dpp v231, v227 row_ror:12 row_mask:0xf bank_mask:0xf
    v_mov_b32_dpp v232, v224 row_ror:8 row_mask:0xf bank_mask:0xf
    v_mov_b32_dpp v233, v225 row_ror:8 row_mask:0xf bank_mask:0xf
    v_mov_b32_dpp v234, v226 row_ror:8 row_mask:0xf bank_mask:0xf
    v_mov_b32_dpp v235, v227 row_ror:8 row_mask:0xf bank_mask:0xf
    v_mov_b32_dpp v236, v224 row_ror:4 row_mask:0xf bank_mask:0xf
    v_mov_b32_dpp v237, v225 row_ror:4 row_mask:0xf bank_mask:0xf
    v_mov_b32_dpp v238, v226 row_ror:4 row_mask:0xf bank_mask:0xf
    v_mov_b32_dpp v239, v227 row_ror:4 row_mask:0xf bank_mask:0xf
    s_waitcnt vmcnt(2)
    s_mov_b32 s56, 65536
    buffer_load_dwordx4 v[80:83], v9, s[36:39], s56 offen offset:0 nt
    s_mul_i32 s7, s3, 2112
    s_add_u32 s7, s7, 17920
    v_mul_u32_u24 v20, 528, v3
    v_lshl_add_u32 v20, v2, 7, v20
    v_add_u32 v20, s7, v20
    s_lshl_b32 s7, s67, 2
    s_lshr_b32 s69, s3, 1
    s_add_u32 s7, s7, s69
    s_mul_i32 s57, s7, 16384
    s_add_u32 s57, s57, s20
    s_and_b32 s69, s3, 1
    s_lshl_b32 s69, s69, 10
    s_add_u32 s57, s57, s69
    s_lshl_b32 s69, s6, 4
    s_add_u32 s20, s20, s69
    s_lshl_b32 s7, s3, 11
    s_add_u32 s7, s7, 1536
    v_add_u32 v15, s7, v9
    v_lshrrev_b32 v5, 5, v0
    v_and_b32 v6, 31, v0
    v_mul_u32_u24 v21, 528, v5
    v_lshl_add_u32 v21, v6, 4, v21
    v_bfe_u32 v22, v0, 4, 3
    v_mul_u32_u24 v22, 16384, v22
    v_and_b32 v6, 14, v1
    v_lshl_add_u32 v22, v6, 7, v22
    v_and_b32 v6, 1, v1
    v_lshl_add_u32 v22, v6, 3, v22
    s_cmp_gt_u32 s58, 0xff
    s_cselect_b32 s69, 262144, 0
    s_add_u32 s20, s20, s69
    s_add_u32 s57, s57, s69
    s_waitcnt vmcnt(2)
    buffer_load_dwordx4 v[84:87], v9, s[36:39], s56 offen offset:1024 nt
    v_lshrrev_b32 v4, 2, v3
    v_lshl_add_u32 v14, v2, 3, v4
    v_lshlrev_b32 v14, 7, v14
    v_and_b32 v5, 3, v3
    v_lshl_add_u32 v14, v5, 3, v14
    v_lshrrev_b32 v4, 1, v4
    v_and_b32 v5, 1, v2
    v_lshl_add_u32 v4, v5, 1, v4
    v_lshl_add_u32 v14, v4, 5, v14
    s_lshl_b32 s7, s3, 12
    s_add_u32 s7, s7, 34816
    v_add_u32 v14, s7, v14
    v_lshlrev_b32 v23, 13, v2
    v_and_b32 v5, 8, v3
    v_lshl_add_u32 v23, v5, 8, v23
    v_and_b32 v5, 7, v1
    v_lshl_add_u32 v23, v5, 4, v23
    s_lshl_b32 s63, s5, 18
    s_lshl_b32 s69, s66, 15
    s_add_u32 s63, s63, s69
    s_add_u32 s63, s63, 786432
    s_lshl_b32 s7, s4, 1
    s_add_u32 s7, s7, s67
    s_lshl_b32 s69, s7, 11
    s_add_u32 s60, s63, s69
    s_lshl_b32 s69, s7, 7
    s_add_u32 s63, s63, s69
    s_lshl_b32 s69, s3, 12
    s_add_u32 s63, s63, s69
    v_lshlrev_b32 v10, 5, v2
    v_lshl_add_u32 v10, v5, 1, v10
    s_lshl_b32 s59, s4, 11
    s_lshl_b32 s69, s5, 10
    s_add_u32 s59, s59, s69
    s_lshl_b32 s69, s66, 7
    s_add_u32 s59, s59, s69
    s_lshl_b32 s69, s67, 4
    s_add_u32 s59, s59, s69
    v_lshlrev_b32 v8, 4, v0
    s_waitcnt vmcnt(2)
    buffer_load_dwordx4 v[88:91], v9, s[36:39], s56 offen offset:2048 nt
    v_perm_b32 v192, v68, v64, s53
    v_perm_b32 v196, v68, v64, s54
    v_perm_b32 v200, v69, v65, s53
    v_perm_b32 v204, v69, v65, s54
    v_perm_b32 v208, v70, v66, s53
    v_perm_b32 v212, v70, v66, s54
    v_perm_b32 v216, v71, v67, s53
    v_perm_b32 v220, v71, v67, s54
    s_waitcnt vmcnt(2)
    buffer_load_dwordx4 v[92:95], v9, s[36:39], s56 offen offset:3072 nt
    v_perm_b32 v193, v76, v72, s53
    v_perm_b32 v197, v76, v72, s54
    v_perm_b32 v201, v77, v73, s53
    v_perm_b32 v205, v77, v73, s54
    v_perm_b32 v209, v78, v74, s53
    v_perm_b32 v213, v78, v74, s54
    v_perm_b32 v217, v79, v75, s53
    v_perm_b32 v221, v79, v75, s54
    s_waitcnt vmcnt(2)
    s_mov_b32 s56, 131072
    buffer_load_dwordx4 v[96:99], v9, s[36:39], s56 offen offset:0 nt
    v_perm_b32 v194, v84, v80, s53
    v_perm_b32 v198, v84, v80, s54
    v_perm_b32 v202, v85, v81, s53
    v_perm_b32 v206, v85, v81, s54
    v_perm_b32 v210, v86, v82, s53
    v_perm_b32 v214, v86, v82, s54
    v_perm_b32 v218, v87, v83, s53
    v_perm_b32 v222, v87, v83, s54
    s_waitcnt vmcnt(2)
    buffer_load_dwordx4 v[100:103], v9, s[36:39], s56 offen offset:1024 nt
    s_waitcnt vmcnt(2)
    buffer_load_dwordx4 v[104:107], v9, s[36:39], s56 offen offset:2048 nt
    v_perm_b32 v195, v92, v88, s53
    v_perm_b32 v199, v92, v88, s54
    v_perm_b32 v203, v93, v89, s53
    v_perm_b32 v207, v93, v89, s54
    v_perm_b32 v211, v94, v90, s53
    v_perm_b32 v215, v94, v90, s54
    v_perm_b32 v219, v95, v91, s53
    v_perm_b32 v223, v95, v91, s54
    v_mfma_f32_16x16x32_bf16 v[32:35], v[192:195], v[224:227], 0
    v_mfma_f32_16x16x32_bf16 v[36:39], v[196:199], v[224:227], 0
    v_mfma_f32_16x16x32_bf16 v[40:43], v[200:203], v[224:227], 0
    v_mfma_f32_16x16x32_bf16 v[44:47], v[204:207], v[224:227], 0
    v_mfma_f32_16x16x32_bf16 v[48:51], v[208:211], v[224:227], 0
    v_mfma_f32_16x16x32_bf16 v[52:55], v[212:215], v[224:227], 0
    v_mfma_f32_16x16x32_bf16 v[56:59], v[216:219], v[224:227], 0
    v_mfma_f32_16x16x32_bf16 v[60:63], v[220:223], v[224:227], 0
    s_waitcnt vmcnt(2)
    buffer_load_dwordx4 v[108:111], v9, s[36:39], s56 offen offset:3072 nt
    s_cmp_ge_u32 s3, 2
    s_cbranch_scc1 L_ml_done
L_cw2:
    ds_read_b32 v30, v28 offset:1288
    s_waitcnt lgkmcnt(0)
    v_readfirstlane_b32 s7, v30
    s_cmp_lt_u32 s7, 8
    s_cbranch_scc1 L_cw2
    v_lshrrev_b32 v4, 5, v0
    v_lshlrev_b32 v5, 6, v4
    ds_read_b128 v[240:243], v5 offset:1024
    ds_read_b128 v[244:247], v5 offset:1040
    ds_read_b128 v[248:251], v5 offset:1056
    ds_read_b128 v[252:255], v5 offset:1072
    s_lshl_b32 s7, s5, 7
    s_add_u32 s7, s7, s62
    s_lshl_b32 s7, s7, 5
    s_add_u32 s7, s7, 32768
    s_xor_b32 s67, s7, 32
    s_andn2_b32 s64, s7, 0x1ff
    v_lshlrev_b32 v11, 3, v1
    v_lshlrev_b32 v7, 3, v4
    s_waitcnt lgkmcnt(0)
    v_max3_f32 v4, v240, v242, v244
    v_max3_f32 v4, v4, v246, v248
    v_max3_f32 v4, v4, v250, v252
    v_max_f32 v4, v4, v254
    v_sub_f32 v240, v240, v4
    v_sub_f32 v242, v242, v4
    v_sub_f32 v244, v244, v4
    v_sub_f32 v246, v246, v4
    v_sub_f32 v248, v248, v4
    v_sub_f32 v250, v250, v4
    v_sub_f32 v252, v252, v4
    v_sub_f32 v254, v254, v4
    v_exp_f32 v240, v240
    v_exp_f32 v242, v242
    v_exp_f32 v244, v244
    v_exp_f32 v246, v246
    v_exp_f32 v248, v248
    v_exp_f32 v250, v250
    v_exp_f32 v252, v252
    v_exp_f32 v254, v254
    v_mul_f32 v5, v240, v241
    v_fmac_f32 v5, v242, v243
    v_fmac_f32 v5, v244, v245
    v_fmac_f32 v5, v246, v247
    v_fmac_f32 v5, v248, v249
    v_fmac_f32 v5, v250, v251
    v_fmac_f32 v5, v252, v253
    v_fmac_f32 v5, v254, v255
    v_rcp_f32 v6, v5
    v_log_f32 v5, v5
    v_mul_f32 v255, v254, v6
    v_mul_f32 v254, v252, v6
    v_mul_f32 v253, v250, v6
    v_mul_f32 v252, v248, v6
    v_mul_f32 v19, v246, v6
    v_mul_f32 v18, v244, v6
    v_mul_f32 v17, v242, v6
    v_mul_f32 v16, v240, v6
    v_add_f32 v240, v4, v5
    v_mov_b32 v241, s52
    v_mov_b32 v244, v7
    s_mov_b32 exec_lo, 1
    s_mov_b32 exec_hi, 1
    s_cmp_gt_u32 s58, 0xff
    s_cbranch_scc1 L_ml_remote
    buffer_store_dwordx2 v[240:241], v7, s[44:47], s7 offen
    s_branch L_ml_st
L_ml_remote:
    buffer_store_dwordx2 v[240:241], v7, s[44:47], s7 offen sc1
L_ml_st:
    s_mov_b64 exec, -1
L_ml_done:
    s_waitcnt vmcnt(2)
    s_mov_b32 s56, 196608
    buffer_load_dwordx4 v[112:115], v9, s[36:39], s56 offen offset:0 nt
    v_perm_b32 v192, v100, v96, s53
    v_perm_b32 v196, v100, v96, s54
    v_perm_b32 v200, v101, v97, s53
    v_perm_b32 v204, v101, v97, s54
    v_perm_b32 v208, v102, v98, s53
    v_perm_b32 v212, v102, v98, s54
    v_perm_b32 v216, v103, v99, s53
    v_perm_b32 v220, v103, v99, s54
    s_waitcnt vmcnt(2)
    buffer_load_dwordx4 v[116:119], v9, s[36:39], s56 offen offset:1024 nt
    s_waitcnt vmcnt(2)
    buffer_load_dwordx4 v[120:123], v9, s[36:39], s56 offen offset:2048 nt
    v_perm_b32 v193, v108, v104, s53
    v_perm_b32 v197, v108, v104, s54
    v_perm_b32 v201, v109, v105, s53
    v_perm_b32 v205, v109, v105, s54
    v_perm_b32 v209, v110, v106, s53
    v_perm_b32 v213, v110, v106, s54
    v_perm_b32 v217, v111, v107, s53
    v_perm_b32 v221, v111, v107, s54
    s_waitcnt vmcnt(2)
    buffer_load_dwordx4 v[124:127], v9, s[36:39], s56 offen offset:3072 nt
    s_waitcnt vmcnt(2)
    s_mov_b32 s56, 262144
    buffer_load_dwordx4 v[128:131], v9, s[36:39], s56 offen offset:0 nt
    v_perm_b32 v194, v116, v112, s53
    v_perm_b32 v198, v116, v112, s54
    v_perm_b32 v202, v117, v113, s53
    v_perm_b32 v206, v117, v113, s54
    v_perm_b32 v210, v118, v114, s53
    v_perm_b32 v214, v118, v114, s54
    v_perm_b32 v218, v119, v115, s53
    v_perm_b32 v222, v119, v115, s54
    s_waitcnt vmcnt(2)
    buffer_load_dwordx4 v[132:135], v9, s[36:39], s56 offen offset:1024 nt
    s_waitcnt vmcnt(2)
    buffer_load_dwordx4 v[136:139], v9, s[36:39], s56 offen offset:2048 nt
    v_perm_b32 v195, v124, v120, s53
    v_perm_b32 v199, v124, v120, s54
    v_perm_b32 v203, v125, v121, s53
    v_perm_b32 v207, v125, v121, s54
    v_perm_b32 v211, v126, v122, s53
    v_perm_b32 v215, v126, v122, s54
    v_perm_b32 v219, v127, v123, s53
    v_perm_b32 v223, v127, v123, s54
    v_mfma_f32_16x16x32_bf16 v[32:35], v[192:195], v[228:231], v[32:35]
    v_mfma_f32_16x16x32_bf16 v[36:39], v[196:199], v[228:231], v[36:39]
    v_mfma_f32_16x16x32_bf16 v[40:43], v[200:203], v[228:231], v[40:43]
    v_mfma_f32_16x16x32_bf16 v[44:47], v[204:207], v[228:231], v[44:47]
    v_mfma_f32_16x16x32_bf16 v[48:51], v[208:211], v[228:231], v[48:51]
    v_mfma_f32_16x16x32_bf16 v[52:55], v[212:215], v[228:231], v[52:55]
    v_mfma_f32_16x16x32_bf16 v[56:59], v[216:219], v[228:231], v[56:59]
    v_mfma_f32_16x16x32_bf16 v[60:63], v[220:223], v[228:231], v[60:63]
    s_waitcnt vmcnt(2)
    buffer_load_dwordx4 v[140:143], v9, s[36:39], s56 offen offset:3072 nt
    s_waitcnt vmcnt(2)
    s_mov_b32 s56, 327680
    buffer_load_dwordx4 v[144:147], v9, s[36:39], s56 offen offset:0 nt
    v_perm_b32 v192, v132, v128, s53
    v_perm_b32 v196, v132, v128, s54
    v_perm_b32 v200, v133, v129, s53
    v_perm_b32 v204, v133, v129, s54
    v_perm_b32 v208, v134, v130, s53
    v_perm_b32 v212, v134, v130, s54
    v_perm_b32 v216, v135, v131, s53
    v_perm_b32 v220, v135, v131, s54
    s_waitcnt vmcnt(2)
    buffer_load_dwordx4 v[148:151], v9, s[36:39], s56 offen offset:1024 nt
    s_waitcnt vmcnt(2)
    buffer_load_dwordx4 v[152:155], v9, s[36:39], s56 offen offset:2048 nt
    v_perm_b32 v193, v140, v136, s53
    v_perm_b32 v197, v140, v136, s54
    v_perm_b32 v201, v141, v137, s53
    v_perm_b32 v205, v141, v137, s54
    v_perm_b32 v209, v142, v138, s53
    v_perm_b32 v213, v142, v138, s54
    v_perm_b32 v217, v143, v139, s53
    v_perm_b32 v221, v143, v139, s54
    s_waitcnt vmcnt(2)
    buffer_load_dwordx4 v[156:159], v9, s[36:39], s56 offen offset:3072 nt
    s_waitcnt vmcnt(2)
    s_mov_b32 s56, 393216
    buffer_load_dwordx4 v[160:163], v9, s[36:39], s56 offen offset:0 nt
    v_perm_b32 v194, v148, v144, s53
    v_perm_b32 v198, v148, v144, s54
    v_perm_b32 v202, v149, v145, s53
    v_perm_b32 v206, v149, v145, s54
    v_perm_b32 v210, v150, v146, s53
    v_perm_b32 v214, v150, v146, s54
    v_perm_b32 v218, v151, v147, s53
    v_perm_b32 v222, v151, v147, s54
    s_waitcnt vmcnt(2)
    buffer_load_dwordx4 v[164:167], v9, s[36:39], s56 offen offset:1024 nt
    s_cmp_ge_u32 s3, 2
    s_cbranch_scc1 L_pl_done
    buffer_load_dwordx2 v[242:243], v244, s[44:47], s67 offen sc1
    buffer_load_dwordx2 v[246:247], v11, s[44:47], s64 offen sc1
L_pl_done:
    s_waitcnt vmcnt(2)
    buffer_load_dwordx4 v[168:171], v9, s[36:39], s56 offen offset:2048 nt
    v_perm_b32 v195, v156, v152, s53
    v_perm_b32 v199, v156, v152, s54
    v_perm_b32 v203, v157, v153, s53
    v_perm_b32 v207, v157, v153, s54
    v_perm_b32 v211, v158, v154, s53
    v_perm_b32 v215, v158, v154, s54
    v_perm_b32 v219, v159, v155, s53
    v_perm_b32 v223, v159, v155, s54
    v_mfma_f32_16x16x32_bf16 v[32:35], v[192:195], v[232:235], v[32:35]
    v_mfma_f32_16x16x32_bf16 v[36:39], v[196:199], v[232:235], v[36:39]
    v_mfma_f32_16x16x32_bf16 v[40:43], v[200:203], v[232:235], v[40:43]
    v_mfma_f32_16x16x32_bf16 v[44:47], v[204:207], v[232:235], v[44:47]
    v_mfma_f32_16x16x32_bf16 v[48:51], v[208:211], v[232:235], v[48:51]
    v_mfma_f32_16x16x32_bf16 v[52:55], v[212:215], v[232:235], v[52:55]
    v_mfma_f32_16x16x32_bf16 v[56:59], v[216:219], v[232:235], v[56:59]
    v_mfma_f32_16x16x32_bf16 v[60:63], v[220:223], v[232:235], v[60:63]
    s_waitcnt vmcnt(2)
    buffer_load_dwordx4 v[172:175], v9, s[36:39], s56 offen offset:3072 nt
    s_waitcnt vmcnt(2)
    s_mov_b32 s56, 458752
    buffer_load_dwordx4 v[176:179], v9, s[36:39], s56 offen offset:0 nt
    v_perm_b32 v192, v164, v160, s53
    v_perm_b32 v196, v164, v160, s54
    v_perm_b32 v200, v165, v161, s53
    v_perm_b32 v204, v165, v161, s54
    v_perm_b32 v208, v166, v162, s53
    v_perm_b32 v212, v166, v162, s54
    v_perm_b32 v216, v167, v163, s53
    v_perm_b32 v220, v167, v163, s54
    s_waitcnt vmcnt(2)
    buffer_load_dwordx4 v[180:183], v9, s[36:39], s56 offen offset:1024 nt
    s_waitcnt vmcnt(2)
    buffer_load_dwordx4 v[184:187], v9, s[36:39], s56 offen offset:2048 nt
    v_perm_b32 v193, v172, v168, s53
    v_perm_b32 v197, v172, v168, s54
    v_perm_b32 v201, v173, v169, s53
    v_perm_b32 v205, v173, v169, s54
    v_perm_b32 v209, v174, v170, s53
    v_perm_b32 v213, v174, v170, s54
    v_perm_b32 v217, v175, v171, s53
    v_perm_b32 v221, v175, v171, s54
    s_waitcnt vmcnt(2)
    buffer_load_dwordx4 v[188:191], v9, s[36:39], s56 offen offset:3072 nt
    s_waitcnt vmcnt(2)
    v_perm_b32 v194, v180, v176, s53
    v_perm_b32 v198, v180, v176, s54
    v_perm_b32 v202, v181, v177, s53
    v_perm_b32 v206, v181, v177, s54
    v_perm_b32 v210, v182, v178, s53
    v_perm_b32 v214, v182, v178, s54
    v_perm_b32 v218, v183, v179, s53
    v_perm_b32 v222, v183, v179, s54
    s_cmp_ge_u32 s3, 2
    s_cbranch_scc1 L_pw_done
    s_mov_b32 s7, 0x10000
L_plpoll:
    v_cmp_ne_u32 vcc, s52, v243
    v_cmp_ne_u32 s[24:25], s52, v247
    s_or_b64 vcc, vcc, s[24:25]
    s_cmp_eq_u64 vcc, 0
    s_cbranch_scc1 L_plok
    s_sub_u32 s7, s7, 1
    s_cbranch_scc1 L_plok
    buffer_load_dwordx2 v[242:243], v244, s[44:47], s67 offen sc1
    buffer_load_dwordx2 v[246:247], v11, s[44:47], s64 offen sc1
    s_waitcnt vmcnt(0)
    s_branch L_plpoll
L_plok:
    v_sub_f32 v242, v242, v240
    v_exp_f32 v242, v242
    s_nop 0
    v_add_f32 v242, 1.0, v242
    v_rcp_f32 v242, v242
    s_nop 0
    v_mul_f32 v16, v16, v242
    v_mul_f32 v17, v17, v242
    v_mul_f32 v18, v18, v242
    v_mul_f32 v19, v19, v242
    v_mul_f32 v252, v252, v242
    v_mul_f32 v253, v253, v242
    v_mul_f32 v254, v254, v242
    v_mul_f32 v255, v255, v242
L_pw_done:
    s_waitcnt vmcnt(0)
    buffer_load_dwordx4 v12, s[40:43], 0 offen offset:0 nt lds
    s_movk_i32 s61, 1024
    buffer_load_dwordx4 v13, s[40:43], s61 offen offset:1024 nt lds
    s_movk_i32 s61, 2048
    buffer_load_dwordx4 v12, s[40:43], s61 offen offset:2048 nt lds
    s_movk_i32 s61, 3072
    buffer_load_dwordx4 v13, s[40:43], s61 offen offset:3072 nt lds
    v_perm_b32 v195, v188, v184, s53
    v_perm_b32 v199, v188, v184, s54
    v_perm_b32 v203, v189, v185, s53
    v_perm_b32 v207, v189, v185, s54
    v_perm_b32 v211, v190, v186, s53
    v_perm_b32 v215, v190, v186, s54
    v_perm_b32 v219, v191, v187, s53
    v_perm_b32 v223, v191, v187, s54
    v_mfma_f32_16x16x32_bf16 v[32:35], v[192:195], v[236:239], v[32:35]
    v_mfma_f32_16x16x32_bf16 v[36:39], v[196:199], v[236:239], v[36:39]
    v_mfma_f32_16x16x32_bf16 v[40:43], v[200:203], v[236:239], v[40:43]
    v_mfma_f32_16x16x32_bf16 v[44:47], v[204:207], v[236:239], v[44:47]
    v_mfma_f32_16x16x32_bf16 v[48:51], v[208:211], v[236:239], v[48:51]
    v_mfma_f32_16x16x32_bf16 v[52:55], v[212:215], v[236:239], v[52:55]
    v_mfma_f32_16x16x32_bf16 v[56:59], v[216:219], v[236:239], v[56:59]
    v_mfma_f32_16x16x32_bf16 v[60:63], v[220:223], v[236:239], v[60:63]
    s_mov_b32 exec_lo, 0x000f000f
    s_mov_b32 exec_hi, 0x000f000f
    ds_write_b128 v20, v[32:35] offset:0
    ds_write_b128 v20, v[36:39] offset:16
    ds_write_b128 v20, v[40:43] offset:32
    ds_write_b128 v20, v[44:47] offset:48
    ds_write_b128 v20, v[48:51] offset:64
    ds_write_b128 v20, v[52:55] offset:80
    ds_write_b128 v20, v[56:59] offset:96
    ds_write_b128 v20, v[60:63] offset:112
    s_mov_b64 exec, -1
    s_waitcnt lgkmcnt(0)
    s_barrier
    s_cmp_ge_u32 s3, 2
    s_cbranch_scc1 L_o_published
    ds_read_b128 v[128:131], v21 offset:17920
    ds_read_b128 v[132:135], v21 offset:20032
    ds_read_b128 v[136:139], v21 offset:22144
    ds_read_b128 v[140:143], v21 offset:24256
    ds_read_b128 v[144:147], v21 offset:26368
    ds_read_b128 v[148:151], v21 offset:28480
    ds_read_b128 v[152:155], v21 offset:30592
    ds_read_b128 v[156:159], v21 offset:32704
    s_waitcnt lgkmcnt(6)
    v_mul_f32 v128, v16, v128
    v_mul_f32 v129, v16, v129
    v_mul_f32 v130, v16, v130
    v_mul_f32 v131, v16, v131
    v_mul_f32 v132, v17, v132
    v_mul_f32 v133, v17, v133
    v_mul_f32 v134, v17, v134
    v_mul_f32 v135, v17, v135
    s_waitcnt lgkmcnt(4)
    v_fmac_f32 v128, v18, v136
    v_fmac_f32 v129, v18, v137
    v_fmac_f32 v130, v18, v138
    v_fmac_f32 v131, v18, v139
    v_fmac_f32 v132, v19, v140
    v_fmac_f32 v133, v19, v141
    v_fmac_f32 v134, v19, v142
    v_fmac_f32 v135, v19, v143
    s_waitcnt lgkmcnt(2)
    v_fmac_f32 v128, v252, v144
    v_fmac_f32 v129, v252, v145
    v_fmac_f32 v130, v252, v146
    v_fmac_f32 v131, v252, v147
    v_fmac_f32 v132, v253, v148
    v_fmac_f32 v133, v253, v149
    v_fmac_f32 v134, v253, v150
    v_fmac_f32 v135, v253, v151
    s_waitcnt lgkmcnt(0)
    v_fmac_f32 v128, v254, v152
    v_fmac_f32 v129, v254, v153
    v_fmac_f32 v130, v254, v154
    v_fmac_f32 v131, v254, v155
    v_fmac_f32 v132, v255, v156
    v_fmac_f32 v133, v255, v157
    v_fmac_f32 v134, v255, v158
    v_fmac_f32 v135, v255, v159
    v_pk_add_f32 v[128:129], v[128:129], v[132:133]
    v_pk_add_f32 v[130:131], v[130:131], v[134:135]
    v_cvt_pk_bf16_f32 v24, v128, v129
    v_cvt_pk_bf16_f32 v25, v130, v131
    v_xor_b32 v25, s52, v25
    v_max_u32 v25, 16, v25
    v_xor_b32 v25, s52, v25
    s_cmp_gt_u32 s58, 0xff
    s_cbranch_scc1 L_o_remote
    buffer_store_dwordx2 v[24:25], v22, s[44:47], s20 offen
    s_branch L_o_published
L_o_remote:
    buffer_store_dwordx2 v[24:25], v22, s[44:47], s20 offen sc1
L_o_published:
    s_barrier
    buffer_load_dwordx4 v[160:163], v9, s[44:47], s57 offen sc1
    v_xor_b32 v4, 32, v14
    v_xor_b32 v5, 64, v14
    v_xor_b32 v6, 0x60, v14
    s_waitcnt vmcnt(1)
    ds_read_b64_tr_b16 v[96:97], v14 offset:0
    ds_read_b64_tr_b16 v[98:99], v14 offset:512
    ds_read_b64_tr_b16 v[100:101], v4 offset:0
    ds_read_b64_tr_b16 v[102:103], v4 offset:512
    ds_read_b64_tr_b16 v[104:105], v5 offset:0
    ds_read_b64_tr_b16 v[106:107], v5 offset:512
    ds_read_b64_tr_b16 v[108:109], v6 offset:0
    ds_read_b64_tr_b16 v[110:111], v6 offset:512
    s_mov_b32 s7, 0x10000
L_apoll:
    s_waitcnt vmcnt(0)
    v_xor_b32 v30, s52, v161
    v_xor_b32 v31, s52, v163
    v_min_u32 v30, v30, v31
    v_cmp_gt_u32 vcc, 16, v30
    s_cmp_eq_u64 vcc, 0
    s_cbranch_scc1 L_aok
    s_sub_u32 s7, s7, 1
    s_cbranch_scc1 L_aok
    s_mov_b64 exec, vcc
    buffer_load_dwordx4 v[160:163], v9, s[44:47], s57 offen sc1
    s_branch L_apoll
L_aok:
    s_mov_b64 exec, -1
    s_waitcnt lgkmcnt(0)
    v_mfma_f32_16x16x32_bf16 v[32:35], v[160:163], v[96:99], 0
    v_mfma_f32_16x16x32_bf16 v[36:39], v[160:163], v[100:103], 0
    v_mfma_f32_16x16x32_bf16 v[40:43], v[160:163], v[104:107], 0
    v_mfma_f32_16x16x32_bf16 v[44:47], v[160:163], v[108:111], 0
    s_nop 4
    v_add_f32 v4, v32, v33
    v_add_f32 v5, v36, v37
    v_add_f32 v6, v40, v41
    v_add_f32 v7, v44, v45
    ds_write_b128 v15, v[4:7]
    v_add_f32 v16, v34, v35
    v_add_f32 v17, v38, v39
    v_add_f32 v18, v42, v43
    v_add_f32 v19, v46, v47
    ds_write_b128 v15, v[16:19] offset:1024
    s_waitcnt lgkmcnt(0)
    s_barrier
    s_cmp_ge_u32 s3, 2
    s_cbranch_scc1 L_fin
    ds_read_b128 v[128:131], v8 offset:1536
    ds_read_b128 v[144:147], v8 offset:3584
    ds_read_b128 v[136:139], v8 offset:5632
    ds_read_b128 v[152:155], v8 offset:7680
    ds_read_b128 v[132:135], v8 offset:9728
    ds_read_b128 v[148:151], v8 offset:11776
    ds_read_b128 v[140:143], v8 offset:13824
    ds_read_b128 v[156:159], v8 offset:15872
    v_mov_b32 v30, s52
    s_mov_b32 s64, 0x07060500
    s_mov_b32 s65, 0x07060501
    s_mov_b32 s66, 0x07060502
    s_mov_b32 s67, 0x07060503
    s_waitcnt lgkmcnt(6)
    v_pk_add_f32 v[128:129], v[128:129], v[144:145]
    v_pk_add_f32 v[130:131], v[130:131], v[146:147]
    s_waitcnt lgkmcnt(4)
    v_pk_add_f32 v[136:137], v[136:137], v[152:153]
    v_pk_add_f32 v[138:139], v[138:139], v[154:155]
    v_pk_add_f32 v[128:129], v[128:129], v[136:137]
    v_pk_add_f32 v[130:131], v[130:131], v[138:139]
    s_waitcnt lgkmcnt(2)
    v_pk_add_f32 v[132:133], v[132:133], v[148:149]
    v_pk_add_f32 v[134:135], v[134:135], v[150:151]
    v_pk_add_f32 v[128:129], v[128:129], v[132:133]
    v_pk_add_f32 v[130:131], v[130:131], v[134:135]
    s_waitcnt lgkmcnt(0)
    v_pk_add_f32 v[140:141], v[140:141], v[156:157]
    v_pk_add_f32 v[142:143], v[142:143], v[158:159]
    v_pk_add_f32 v[128:129], v[128:129], v[140:141]
    v_pk_add_f32 v[130:131], v[130:131], v[142:143]
    v_perm_b32 v24, v128, v30, s64
    v_perm_b32 v25, v129, v30, s65
    v_perm_b32 v26, v130, v30, s66
    v_perm_b32 v27, v131, v30, s67
    buffer_store_dwordx4 v[24:27], v23, s[44:47], s63 offen sc1
    s_cmp_lg_u32 s3, 0
    s_cbranch_scc1 L_fin
    s_mov_b32 s7, 0x10000
    s_mov_b32 s64, 0x0c0c0400
    s_mov_b32 s65, 0x04000c0c
    s_mov_b32 s66, 0xffffff00
L_p4poll:
    buffer_load_dwordx4 v[4:7], v9, s[44:47], s60 offen sc1
    buffer_load_dwordx4 v[16:19], v9, s[44:47], s60 offen offset:1024 sc1
    s_waitcnt vmcnt(1)
    v_perm_b32 v20, v5, v4, s64
    v_perm_b32 v21, v7, v6, s65
    v_bitop3_b32 v20, v20, v21, s52 bitop3:0x56
    v_and_b32 v4, s66, v4
    v_and_b32 v5, s66, v5
    v_and_b32 v6, s66, v6
    v_and_b32 v7, s66, v7
    s_waitcnt vmcnt(0)
    v_perm_b32 v30, v17, v16, s64
    v_perm_b32 v31, v19, v18, s65
    v_bitop3_b32 v30, v30, v31, s52 bitop3:0x56
    v_or_b32 v21, v20, v30
    v_cmp_ne_u32 vcc, 0, v21
    v_and_b32 v16, s66, v16
    v_and_b32 v17, s66, v17
    v_and_b32 v18, s66, v18
    v_and_b32 v19, s66, v19
    s_cmp_eq_u64 vcc, 0
    s_cbranch_scc1 L_p4ok
    s_mov_b64 exec, vcc
    s_sub_u32 s7, s7, 1
    s_cbranch_scc0 L_p4poll
L_p4ok:
    s_mov_b64 exec, -1
    v_pk_add_f32 v[4:5], v[4:5], v[16:17]
    v_pk_add_f32 v[6:7], v[6:7], v[18:19]
    s_nop 1
    v_permlane32_swap_b32 v4, v6
    v_permlane32_swap_b32 v5, v7
    v_add_f32 v4, v4, v6
    v_add_f32 v5, v5, v7
    s_nop 1
    v_permlane16_swap_b32 v4, v5
    v_add_f32 v4, v4, v5
    s_nop 1
    v_add_f32_dpp v4, v4, v4 row_ror:8 row_mask:0xf bank_mask:0xf
    v_cvt_pk_bf16_f32 v4, v4, v4
    s_mov_b32 exec_lo, 0x00ff00ff
    s_mov_b32 exec_hi, 0x00ff00ff
    buffer_store_short v4, v10, s[48:51], s59 offen
    s_cmp_lg_u32 s62, 0
    s_cbranch_scc1 L_fin
    s_mov_b64 exec, 1
    v_mov_b32 v4, s52
    s_lshl_b32 s61, s5, 8
    buffer_store_dword v4, off, s[44:47], s61
L_fin:
L_end:
    s_endpgm
L_qslow:
L_cw3:
    ds_read_b32 v30, v28 offset:1292
    s_waitcnt lgkmcnt(0)
    v_readfirstlane_b32 s7, v30
    s_cmp_lt_u32 s7, 1
    s_cbranch_scc1 L_cw3
    ds_read_b128 v[24:27], v9 offset:1536
    v_lshrrev_b32 v20, 3, v1
    v_lshl_add_u32 v21, v20, 1, s6
    v_and_b32 v21, 15, v21
    v_lshlrev_b32 v20, 14, v20
    v_lshl_add_u32 v20, v21, 7, v20
    v_and_b32 v21, 7, v1
    v_lshl_add_u32 v20, v21, 4, v20
    s_add_u32 s69, s20, 262144
    s_add_u32 s61, s59, 262144
    s_waitcnt lgkmcnt(0)
    buffer_store_dwordx4 v[24:27], v20, s[44:47], s69 offen sc1
    s_waitcnt vmcnt(0)
    s_mov_b32 s7, 0x10000
L_qs_loop:
    v_or_b32 v30, v5, v7
    v_cmp_lt_u32 vcc, 15, v30
    s_cmp_eq_u64 vcc, 0
    s_cbranch_scc1 L_qok
    s_sub_u32 s7, s7, 1
    s_cbranch_scc1 L_qok
    buffer_load_dwordx4 v[4:7], v15, s[44:47], s59 offen sc1
    buffer_load_dwordx4 v[16:19], v15, s[44:47], s61 offen sc1
    s_waitcnt vmcnt(0)
    v_xor_b32 v5, s52, v5
    v_xor_b32 v7, s52, v7
    v_xor_b32 v17, s52, v17
    v_xor_b32 v19, s52, v19
    v_or_b32 v30, v17, v19
    v_cmp_gt_u32 vcc, 16, v30
    s_nop 1
    v_cndmask_b32 v4, v4, v16, vcc
    v_cndmask_b32 v5, v5, v17, vcc
    v_cndmask_b32 v6, v6, v18, vcc
    v_cndmask_b32 v7, v7, v19, vcc
    s_branch L_qs_loop
.section .rodata,"a"
.p2align 6
.amdhsa_kernel concat_heads__sliding_block_cached__sliding_block_cached__decode_kernel
  .amdhsa_next_free_vgpr 256
  .amdhsa_next_free_sgpr 102
  .amdhsa_accum_offset 256
  .amdhsa_group_segment_fixed_size 0
  .amdhsa_kernarg_size 104
  .amdhsa_user_sgpr_count 2
  .amdhsa_user_sgpr_kernarg_segment_ptr 1
  .amdhsa_system_sgpr_workgroup_id_x 1
  .amdhsa_float_denorm_mode_32 3
.end_amdhsa_kernel
```
